```python
import torch

def _softmax(x, axis=-1):
    return torch.softmax(x, dim=axis)
def _gelu(x):
    return torch.nn.functional.gelu(x, approximate="tanh")
def _silu(x):
    return torch.nn.functional.silu(x)
def _sigmoid(x):
    return torch.sigmoid(x)
def _layernorm(x, axis=-1, eps=1e-5):
    m = x.mean(dim=axis, keepdim=True)
    v = x.var(dim=axis, keepdim=True, unbiased=False)
    return (x - m) / torch.sqrt(v + eps)
def _scatter_add(tgt, idx, src, axis=0):
    return tgt.clone().index_add_(axis, idx, src)
def _segment_sum(src, seg, n):
    out = torch.zeros((n,) + src.shape[1:], dtype=src.dtype)
    return out.index_add_(0, seg, src)
def _pad(x, pw):
    flat = tuple(v for pair in reversed(pw) for v in pair)
    return torch.nn.functional.pad(x, flat)

kernel_name = 'standalone__geglu_ffn__decode'

def setup_inputs():

    _w = (lambda a: (lambda t: t.to(torch.bfloat16) if t.is_floating_point() else t)(torch.as_tensor(a)))
    B, S, D, F = 1, 1, 1024, 3584
    return {
        "x": _w((lambda *s: torch.randn(*s, dtype=torch.bfloat16) * 0.05)(B, S, D)),
        "w_gate": _w((lambda *s: torch.randn(*s, dtype=torch.bfloat16) * 0.05)(D, F)),
        "w_up": _w((lambda *s: torch.randn(*s, dtype=torch.bfloat16) * 0.05)(D, F)),
        "w_down": _w((lambda *s: torch.randn(*s, dtype=torch.bfloat16) * 0.05)(F, D)),
    }

def reference(x, w_gate, w_up, w_down):
    return (_gelu(x @ w_gate) * (x @ w_up)) @ w_down
```

```asm
; @launch grid=(256,1,1) block=(512,1,1) lds=2304
.amdgcn_target "amdgcn-amd-amdhsa--gfx950"
.text
.globl standalone__geglu_ffn__decode_kernel
.p2align 12
.p2align 8
.type standalone__geglu_ffn__decode_kernel,@function
standalone__geglu_ffn__decode_kernel:
    s_cmp_ge_u32 s2, 256
    s_cbranch_scc1 L_end
    s_load_dwordx8 s[8:15], s[0:1], 0
    s_load_dwordx4 s[16:19], s[0:1], 32
    s_load_dwordx2 s[20:21], s[0:1], 48
    v_lshrrev_b32 v1, 6, v0
    s_and_b32 s22, s2, 7
    v_readfirstlane_b32 s3, v1
    s_lshr_b32 s23, s2, 3
    s_cmp_lt_u32 s3, 4
    s_cbranch_scc1 L_common
    s_mov_b64 exec, 0
    s_cmp_eq_u32 s3, 4
    s_cbranch_scc1 L_pad1
    s_cmp_eq_u32 s3, 5
    s_cbranch_scc1 L_pad2
    s_cmp_eq_u32 s3, 6
    s_cbranch_scc1 L_pad3
    s_branch L_pad4
L_common:
    s_mov_b64 exec, -1
    s_mul_i32 s24, s22, 7
    s_lshr_b32 s26, s23, 2
    s_and_b32 s25, s23, 3
    s_add_u32 s27, s22, 3
    s_and_b32 s27, s27, 7
    s_cmp_eq_u32 s26, 7
    s_cselect_b32 s31, 1, 0
    s_cselect_b32 s26, s27, s26
    s_cmp_eq_u32 s26, 7
    s_cbranch_scc1 L_end
    s_cmp_eq_u32 s26, s27
    s_cselect_b32 s32, 1, 0
    s_add_u32 s24, s24, s26
    s_mov_b32 s28, 0x05040100
    s_mov_b32 s29, 0x07060302
    v_and_b32 v2, 7, v0
    v_and_b32 v7, 63, v0
    s_cmp_gt_u32 s3, 3
    s_cbranch_scc1 L_B
    v_lshrrev_b32 v1, 3, v0
    s_lshl_b32 s33, s25, 1
    s_add_u32 s33, s33, s31
    s_mul_i32 s26, s33, 229376
    s_lshl_b32 s27, s24, 7
    s_add_u32 s26, s26, s27
    v_mul_u32_u24 v3, 14336, v1
    v_lshl_add_u32 v3, v2, 4, v3
    v_add_u32 v96, s26, v3
    s_lshl_b32 s27, s33, 6
    v_lshlrev_b32 v4, 2, v1
    v_add_u32 v4, s27, v4
    v_add_u32 v97, 7168, v96
    v_add_u32 v98, 1835008, v96
    v_add_u32 v99, 1842176, v96
    v_add_u32 v100, 3670016, v96
    v_add_u32 v101, 3677184, v96
    v_add_u32 v102, 5505024, v96
    v_add_u32 v103, 5512192, v96
    v_lshlrev_b32 v1, 3, v0
    s_lshr_b32 s26, s3, 1
    s_and_b32 s26, s26, s32
    s_waitcnt lgkmcnt(0)
    s_cbranch_scc1 L_A_idle
    s_setprio 3
    global_load_dword v8, v4, s[8:9] offset:0
    global_load_dword v9, v4, s[8:9] offset:512
    global_load_dword v10, v4, s[8:9] offset:1024
    global_load_dword v11, v4, s[8:9] offset:1536
    global_load_dwordx4 v[32:35], v96, s[10:11] nt
    global_load_dwordx4 v[64:67], v96, s[12:13] nt
    global_load_dwordx4 v[36:39], v97, s[10:11] nt
    global_load_dwordx4 v[68:71], v97, s[12:13] nt
    s_setprio 2
    global_load_dwordx4 v[40:43], v98, s[10:11] nt
    global_load_dwordx4 v[72:75], v98, s[12:13] nt
    global_load_dwordx4 v[44:47], v99, s[10:11] nt
    global_load_dwordx4 v[76:79], v99, s[12:13] nt
    s_setprio 1
    global_load_dwordx4 v[48:51], v100, s[10:11] nt
    global_load_dwordx4 v[80:83], v100, s[12:13] nt
    global_load_dwordx4 v[52:55], v101, s[10:11] nt
    global_load_dwordx4 v[84:87], v101, s[12:13] nt
    s_setprio 0
    global_load_dwordx4 v[56:59], v102, s[10:11] nt
    global_load_dwordx4 v[88:91], v102, s[12:13] nt
    global_load_dwordx4 v[60:63], v103, s[10:11] nt
    global_load_dwordx4 v[92:95], v103, s[12:13] nt
    s_load_dwordx2 s[40:41], s[20:21], 520200
    s_lshl_b32 s36, s22, 4
    s_or_b32 s36, s36, s23
    s_lshl_b32 s26, s36, 12
    s_add_u32 s26, s26, 524288
    v_lshl_add_u32 v103, v7, 4, s26
    v_and_b32 v3, 3, v7
    v_lshlrev_b32 v5, 4, v3
    v_bfe_u32 v3, v7, 5, 1
    v_lshl_add_u32 v5, v3, 1, v5
    s_lshr_b32 s27, s36, 3
    s_lshl_b32 s27, s27, 7
    s_and_b32 s33, s36, 1
    s_lshl_b32 s33, s33, 6
    s_add_u32 s27, s27, s33
    s_bfe_u32 s33, s36, 0x20001
    s_lshl_b32 s33, s33, 2
    s_add_u32 s27, s27, s33
    v_add_u32 v5, s27, v5
    v_and_b32 v3, 28, v7
    v_cmp_eq_u32 s[38:39], 0, v3
    s_lshl_b32 s26, s22, 10
    s_add_u32 s26, s26, 491520
    v_lshl_add_u32 v104, v7, 3, s26
    s_cmp_lg_u32 s31, 0
    s_cselect_b32 s42, 32, 20
    v_lshlrev_b32 v105, 4, v2
    v_lshrrev_b32 v3, 3, v7
    v_lshl_add_u32 v105, v3, 1, v105
    s_lshl_b32 s26, s24, 13
    s_lshl_b32 s27, s31, 2
    s_add_u32 s27, s27, s25
    s_lshl_b32 s27, s27, 10
    s_add_u32 s27, s27, s26
    v_lshl_add_u32 v4, v7, 4, s27
    v_xor_b32 v97, 1024, v4
    v_xor_b32 v98, 2048, v4
    v_xor_b32 v99, 3072, v4
    s_add_u32 s33, s26, 4096
    v_lshl_add_u32 v96, v7, 4, s33
    v_xor_b32 v3, 512, v1
    v_xor_b32 v6, 1024, v1
    v_xor_b32 v107, 1536, v1
    v_mov_b32 v100, 2176
    v_mov_b32 v101, 1
    s_mov_b32 s35, 200000
    s_lshl_b32 s34, s32, 1
    s_sub_u32 s34, 3, s34
    s_mov_b32 s43, 0
    v_mov_b32 v106, 0xc0135761
    v_mov_b64 v[12:13], 0
    v_mov_b64 v[14:15], 0
    v_mov_b64 v[16:17], 0
    v_mov_b64 v[18:19], 0
    v_mov_b64 v[20:21], 0
    v_mov_b64 v[22:23], 0
    v_mov_b64 v[24:25], 0
    v_mov_b64 v[26:27], 0
    s_waitcnt vmcnt(13)
    v_perm_b32 v28, v36, v32, s28
    v_perm_b32 v29, v36, v32, s29
    v_dot2c_f32_bf16 v12, v28, v8
    v_dot2c_f32_bf16 v13, v29, v8
    v_perm_b32 v28, v37, v33, s28
    v_perm_b32 v29, v37, v33, s29
    v_dot2c_f32_bf16 v14, v28, v8
    v_dot2c_f32_bf16 v15, v29, v8
    v_perm_b32 v28, v38, v34, s28
    v_perm_b32 v29, v38, v34, s29
    v_dot2c_f32_bf16 v16, v28, v8
    v_dot2c_f32_bf16 v17, v29, v8
    v_perm_b32 v28, v39, v35, s28
    v_perm_b32 v29, v39, v35, s29
    v_dot2c_f32_bf16 v18, v28, v8
    v_dot2c_f32_bf16 v19, v29, v8
    s_waitcnt vmcnt(12)
    v_perm_b32 v28, v68, v64, s28
    v_perm_b32 v29, v68, v64, s29
    v_dot2c_f32_bf16 v20, v28, v8
    v_dot2c_f32_bf16 v21, v29, v8
    v_perm_b32 v28, v69, v65, s28
    v_perm_b32 v29, v69, v65, s29
    v_dot2c_f32_bf16 v22, v28, v8
    v_dot2c_f32_bf16 v23, v29, v8
    v_perm_b32 v28, v70, v66, s28
    v_perm_b32 v29, v70, v66, s29
    v_dot2c_f32_bf16 v24, v28, v8
    v_dot2c_f32_bf16 v25, v29, v8
    v_perm_b32 v28, v71, v67, s28
    v_perm_b32 v29, v71, v67, s29
    v_dot2c_f32_bf16 v26, v28, v8
    v_dot2c_f32_bf16 v27, v29, v8
    s_waitcnt vmcnt(9)
    s_barrier
    v_perm_b32 v28, v44, v40, s28
    v_perm_b32 v29, v44, v40, s29
    v_dot2c_f32_bf16 v12, v28, v9
    v_dot2c_f32_bf16 v13, v29, v9
    v_perm_b32 v28, v45, v41, s28
    v_perm_b32 v29, v45, v41, s29
    v_dot2c_f32_bf16 v14, v28, v9
    v_dot2c_f32_bf16 v15, v29, v9
    v_perm_b32 v28, v46, v42, s28
    v_perm_b32 v29, v46, v42, s29
    v_dot2c_f32_bf16 v16, v28, v9
    v_dot2c_f32_bf16 v17, v29, v9
    v_perm_b32 v28, v47, v43, s28
    v_perm_b32 v29, v47, v43, s29
    v_dot2c_f32_bf16 v18, v28, v9
    v_dot2c_f32_bf16 v19, v29, v9
    s_waitcnt vmcnt(8)
    v_perm_b32 v28, v76, v72, s28
    v_perm_b32 v29, v76, v72, s29
    v_dot2c_f32_bf16 v20, v28, v9
    v_dot2c_f32_bf16 v21, v29, v9
    v_perm_b32 v28, v77, v73, s28
    v_perm_b32 v29, v77, v73, s29
    v_dot2c_f32_bf16 v22, v28, v9
    v_dot2c_f32_bf16 v23, v29, v9
    v_perm_b32 v28, v78, v74, s28
    v_perm_b32 v29, v78, v74, s29
    v_dot2c_f32_bf16 v24, v28, v9
    v_dot2c_f32_bf16 v25, v29, v9
    v_perm_b32 v28, v79, v75, s28
    v_perm_b32 v29, v79, v75, s29
    v_dot2c_f32_bf16 v26, v28, v9
    v_dot2c_f32_bf16 v27, v29, v9
    s_waitcnt vmcnt(5)
L_pad1:
    s_cbranch_execz L_common
    v_perm_b32 v28, v52, v48, s28
    v_perm_b32 v29, v52, v48, s29
    v_dot2c_f32_bf16 v12, v28, v10
    v_dot2c_f32_bf16 v13, v29, v10
    v_perm_b32 v28, v53, v49, s28
    v_perm_b32 v29, v53, v49, s29
    v_dot2c_f32_bf16 v14, v28, v10
    v_dot2c_f32_bf16 v15, v29, v10
    v_perm_b32 v28, v54, v50, s28
    v_perm_b32 v29, v54, v50, s29
    v_dot2c_f32_bf16 v16, v28, v10
    v_dot2c_f32_bf16 v17, v29, v10
    v_perm_b32 v28, v55, v51, s28
    v_perm_b32 v29, v55, v51, s29
    v_dot2c_f32_bf16 v18, v28, v10
    v_dot2c_f32_bf16 v19, v29, v10
    s_waitcnt vmcnt(4)
    s_waitcnt lgkmcnt(0)
    s_add_u32 s40, s40, 0x7F4A7C15
    s_add_u32 s41, s41, 0x9E3779B9
    v_mov_b32 v33, s40
    v_mov_b32 v35, s41
    v_perm_b32 v28, v84, v80, s28
    v_perm_b32 v29, v84, v80, s29
    v_dot2c_f32_bf16 v20, v28, v10
    v_dot2c_f32_bf16 v21, v29, v10
    v_perm_b32 v28, v85, v81, s28
    v_perm_b32 v29, v85, v81, s29
    v_dot2c_f32_bf16 v22, v28, v10
    v_dot2c_f32_bf16 v23, v29, v10
    v_perm_b32 v28, v86, v82, s28
    v_perm_b32 v29, v86, v82, s29
    v_dot2c_f32_bf16 v24, v28, v10
    v_dot2c_f32_bf16 v25, v29, v10
    v_perm_b32 v28, v87, v83, s28
    v_perm_b32 v29, v87, v83, s29
    v_dot2c_f32_bf16 v26, v28, v10
    v_dot2c_f32_bf16 v27, v29, v10
    s_waitcnt vmcnt(1)
    v_perm_b32 v28, v60, v56, s28
    v_perm_b32 v29, v60, v56, s29
    v_dot2c_f32_bf16 v12, v28, v11
    v_dot2c_f32_bf16 v13, v29, v11
    v_perm_b32 v28, v61, v57, s28
    v_perm_b32 v29, v61, v57, s29
    v_dot2c_f32_bf16 v14, v28, v11
    v_dot2c_f32_bf16 v15, v29, v11
    v_perm_b32 v28, v62, v58, s28
    v_perm_b32 v29, v62, v58, s29
    v_dot2c_f32_bf16 v16, v28, v11
    v_dot2c_f32_bf16 v17, v29, v11
    v_perm_b32 v28, v63, v59, s28
    v_perm_b32 v29, v63, v59, s29
    v_dot2c_f32_bf16 v18, v28, v11
    v_dot2c_f32_bf16 v19, v29, v11
    s_nop 0
    v_permlane32_swap_b32 v12, v16
    v_permlane32_swap_b32 v13, v17
    v_permlane32_swap_b32 v14, v18
    v_permlane32_swap_b32 v15, v19
    v_add_f32 v12, v12, v16
    v_add_f32 v13, v13, v17
    v_add_f32 v14, v14, v18
    v_add_f32 v15, v15, v19
    s_nop 0
    v_permlane16_swap_b32 v12, v14
    v_permlane16_swap_b32 v13, v15
    v_add_f32 v12, v12, v14
    v_add_f32 v13, v13, v15
    s_nop 0
    v_add_f32_dpp v30, v12, v12 row_ror:8 row_mask:0xf bank_mask:0x3
    v_add_f32_dpp v30, v13, v13 row_ror:8 row_mask:0xf bank_mask:0xc
    s_waitcnt vmcnt(0)
    ds_read_b32 v102, v100 offset:4
    ds_read_b64 v[38:39], v3
    ds_read_b64 v[40:41], v6
    ds_read_b64 v[42:43], v107
    v_perm_b32 v28, v92, v88, s28
    v_perm_b32 v29, v92, v88, s29
    v_dot2c_f32_bf16 v20, v28, v11
    v_dot2c_f32_bf16 v21, v29, v11
    v_perm_b32 v28, v93, v89, s28
    v_perm_b32 v29, v93, v89, s29
    v_dot2c_f32_bf16 v22, v28, v11
    v_dot2c_f32_bf16 v23, v29, v11
    v_perm_b32 v28, v94, v90, s28
    v_perm_b32 v29, v94, v90, s29
    v_dot2c_f32_bf16 v24, v28, v11
    v_dot2c_f32_bf16 v25, v29, v11
    v_perm_b32 v28, v95, v91, s28
    v_perm_b32 v29, v95, v91, s29
    v_dot2c_f32_bf16 v26, v28, v11
    v_dot2c_f32_bf16 v27, v29, v11
    s_nop 0
    v_permlane32_swap_b32 v20, v24
    v_permlane32_swap_b32 v21, v25
    v_permlane32_swap_b32 v22, v26
    v_permlane32_swap_b32 v23, v27
    v_add_f32 v20, v20, v24
    v_add_f32 v21, v21, v25
    v_add_f32 v22, v22, v26
    v_add_f32 v23, v23, v27
    s_nop 0
    v_permlane16_swap_b32 v20, v22
    v_permlane16_swap_b32 v21, v23
    v_add_f32 v20, v20, v22
    v_add_f32 v21, v21, v23
    s_nop 0
    v_add_f32_dpp v31, v20, v20 row_ror:8 row_mask:0xf bank_mask:0x3
    v_add_f32_dpp v31, v21, v21 row_ror:8 row_mask:0xf bank_mask:0xc
    s_waitcnt lgkmcnt(0)
    v_readfirstlane_b32 s33, v102
    v_add_f32 v20, v30, v38
    v_add_f32 v21, v31, v39
    s_cmp_lg_u32 s33, s34
    s_cbranch_scc1 L_A_slow
L_A_last:
    v_add_f32 v24, v40, v42
    v_add_f32 v25, v41, v43
    s_cmp_lg_u32 s31, 0
    v_add_f32 v32, v20, v24
    v_add_f32 v34, v21, v25
    global_store_dwordx4 v4, v[32:35], s[20:21]
    s_cbranch_scc1 L_trig0
    s_branch L_x1_cont
L_x1:
    s_sub_u32 s35, s35, 1
    s_cbranch_scc1 L_end
    s_cmp_eq_u32 s35, 199988
    s_cbranch_scc1 L_x1_wt
L_x1_cont:
    global_load_dwordx4 v[36:39], v97, s[20:21] sc1
    global_load_dwordx4 v[40:43], v98, s[20:21] sc1
    global_load_dwordx4 v[44:47], v99, s[20:21] sc1
    s_cmp_lg_u32 s32, 0
    s_cbranch_scc1 L_x1_c3
    s_waitcnt vmcnt(0)
    v_xor_b32 v28, s40, v37
    v_xor_b32 v29, s41, v39
    v_bitop3_b32 v28, v28, v41, s40 bitop3:0xf6
    v_bitop3_b32 v29, v29, v43, s41 bitop3:0xf6
    v_bitop3_b32 v28, v28, v45, s40 bitop3:0xf6
    v_bitop3_b32 v29, v29, v47, s41 bitop3:0xf6
    v_or_b32 v28, v28, v29
    v_cmp_ne_u32 vcc, 0, v28
    v_add_f32 v20, v32, v36
    v_add_f32 v21, v34, v38
    v_add_f32 v24, v40, v44
    v_add_f32 v25, v42, v46
    s_cbranch_vccnz L_x1
L_x1_sum:
L_pad2:
    s_cbranch_execz L_common
    v_add_f32 v12, v20, v24
    v_add_f32 v16, v21, v25
    v_cvt_pk_bf16_f32 v12, v12, v16
    v_and_b32 v16, 0xffff0000, v12
    v_lshlrev_b32 v12, 16, v12
    v_mul_f32 v13, v12, v12
    v_fmac_f32 v106, 0xbdd2d3e8, v13
    v_mul_f32 v13, v12, v106
    v_exp_f32 v13, v13
    s_nop 0
    v_add_f32 v13, 1.0, v13
    v_rcp_f32 v13, v13
    s_nop 0
    v_mul_f32 v12, v12, v13
    v_cvt_pk_bf16_f32 v12, v12, v12
    v_lshlrev_b32 v12, 16, v12
    v_mul_f32 v12, v12, v16
    v_cvt_pk_bf16_f32 v12, v12, v12
    ds_write_b16 v105, v12 offset:2048
    ds_write_b32 v100, v101
    s_mov_b32 s35, 200000
    v_mov_b32 v48, 0
    v_mov_b32 v49, s40
    v_mov_b32 v50, 0
    v_mov_b32 v51, s41
L_trig0:
    s_mov_b64 exec, 0x0fffffff
L_trig:
    global_load_dwordx2 v[28:29], v104, s[20:21] sc1
    s_sub_u32 s42, s42, 1
    s_cbranch_scc1 L_trig_to
    s_waitcnt vmcnt(0)
    v_xor_b32 v28, s40, v28
    v_bitop3_b32 v28, v28, v29, s41 bitop3:0xf6
    v_cmp_ne_u32 vcc, 0, v28
    s_cbranch_vccnz L_trig
    s_mov_b64 exec, -1
L_trig_done:
    s_cmp_ge_u32 s2, 128
    s_cbranch_scc1 L_A_done
    global_load_dwordx4 v[36:39], v103, s[20:21] offset:0 sc1
    global_load_dwordx4 v[40:43], v103, s[20:21] offset:1024 sc1
    global_load_dwordx4 v[44:47], v103, s[20:21] offset:2048 sc1
    s_mov_b32 exec_hi, 0
    global_load_dwordx4 v[48:51], v103, s[20:21] offset:3072 sc1
    s_mov_b32 exec_hi, -1
    s_waitcnt vmcnt(0)
L_x2_chk:
    v_xor_b32 v28, s40, v37
    v_bitop3_b32 v28, v28, v39, s41 bitop3:0xf6
    v_cmp_ne_u32 s[52:53], 0, v28
    v_xor_b32 v29, s40, v41
    v_bitop3_b32 v29, v29, v43, s41 bitop3:0xf6
    v_cmp_ne_u32 s[54:55], 0, v29
    v_xor_b32 v30, s40, v45
    v_bitop3_b32 v30, v30, v47, s41 bitop3:0xf6
    v_cmp_ne_u32 s[56:57], 0, v30
    v_xor_b32 v31, s40, v49
    v_bitop3_b32 v31, v31, v51, s41 bitop3:0xf6
    v_cmp_ne_u32 s[58:59], 0, v31
    v_add_f32 v20, v36, v40
    v_add_f32 v21, v38, v42
    s_or_b64 s[60:61], s[52:53], s[54:55]
    s_or_b64 s[62:63], s[56:57], s[58:59]
    v_add_f32 v22, v44, v48
    v_add_f32 v23, v46, v50
    s_or_b64 s[60:61], s[60:61], s[62:63]
    v_add_f32 v24, v20, v22
    v_add_f32 v25, v21, v23
    s_cbranch_scc1 L_x2_retry
    s_nop 0
    v_permlane32_swap_b32 v24, v25
    v_add_f32 v20, v24, v25
    v_add_f32 v21, v24, v25
    s_nop 1
    v_permlane16_swap_b32 v20, v21
    v_add_f32 v20, v20, v21
    s_nop 1
    v_add_f32_dpp v20, v20, v20 row_ror:8 row_mask:0xf bank_mask:0xf
    s_nop 1
    v_add_f32_dpp v20, v20, v20 row_ror:4 row_mask:0xf bank_mask:0xf
    v_cvt_pk_bf16_f32 v20, v20, v20
    s_mov_b64 exec, s[38:39]
    global_store_short v5, v20, s[16:17]
    s_cmp_lg_u32 s2, 0
    s_cbranch_scc1 L_A_done
    s_mov_b64 exec, 1
    v_mov_b32 v22, s40
    v_mov_b32 v23, s41
    v_mov_b32 v24, 520200
    global_store_dwordx2 v24, v[22:23], s[20:21]
L_A_done:
    s_endpgm
L_x2_retry:
    s_mov_b64 exec, s[52:53]
    global_load_dwordx4 v[36:39], v103, s[20:21] offset:0 sc1
    s_mov_b64 exec, s[54:55]
    global_load_dwordx4 v[40:43], v103, s[20:21] offset:1024 sc1
    s_mov_b64 exec, s[56:57]
    global_load_dwordx4 v[44:47], v103, s[20:21] offset:2048 sc1
    s_mov_b64 exec, s[58:59]
    global_load_dwordx4 v[48:51], v103, s[20:21] offset:3072 sc1
    s_mov_b64 exec, -1
    s_sub_u32 s35, s35, 1
    s_cbranch_scc1 L_end
    s_waitcnt vmcnt(0)
    s_branch L_x2_chk
L_trig_to:
    s_mov_b64 exec, -1
    global_store_dwordx4 v4, v[32:35], s[20:21] sc1
    s_branch L_trig_done
L_A_slow:
    ds_write_b64 v1, v[30:31]
    s_mov_b64 exec, 1
    ds_add_rtn_u32 v102, v100, v101 offset:4
    s_mov_b64 exec, -1
    ds_read_b64 v[38:39], v3
    ds_read_b64 v[40:41], v6
    ds_read_b64 v[42:43], v107
    s_waitcnt lgkmcnt(0)
    v_readfirstlane_b32 s33, v102
    v_add_f32 v20, v30, v38
    v_add_f32 v21, v31, v39
    s_cmp_eq_u32 s33, s34
    s_cbranch_scc1 L_A_last
    s_endpgm
L_x1_wt:
    global_store_dwordx4 v4, v[32:35], s[20:21] sc1
    s_branch L_x1_cont
L_x1_c3:
    global_load_dwordx4 v[48:51], v96, s[20:21] sc1
    global_load_dwordx4 v[52:55], v96, s[20:21] offset:1024 sc1
    global_load_dwordx4 v[56:59], v96, s[20:21] offset:2048 sc1
    global_load_dwordx4 v[60:63], v96, s[20:21] offset:3072 sc1
    s_waitcnt vmcnt(0)
    v_xor_b32 v28, s40, v37
    v_xor_b32 v29, s41, v39
    v_bitop3_b32 v28, v28, v41, s40 bitop3:0xf6
    v_bitop3_b32 v29, v29, v43, s41 bitop3:0xf6
    v_bitop3_b32 v28, v28, v45, s40 bitop3:0xf6
    v_bitop3_b32 v29, v29, v47, s41 bitop3:0xf6
    v_bitop3_b32 v28, v28, v49, s40 bitop3:0xf6
    v_bitop3_b32 v29, v29, v51, s41 bitop3:0xf6
    v_bitop3_b32 v28, v28, v53, s40 bitop3:0xf6
    v_bitop3_b32 v29, v29, v55, s41 bitop3:0xf6
    v_bitop3_b32 v28, v28, v57, s40 bitop3:0xf6
    v_bitop3_b32 v29, v29, v59, s41 bitop3:0xf6
    v_bitop3_b32 v28, v28, v61, s40 bitop3:0xf6
    v_bitop3_b32 v29, v29, v63, s41 bitop3:0xf6
    v_or_b32 v28, v28, v29
    v_cmp_ne_u32 vcc, 0, v28
    s_cbranch_vccnz L_x1
    v_add_f32 v20, v32, v36
    v_add_f32 v21, v34, v38
    v_add_f32 v24, v40, v44
    v_add_f32 v25, v42, v46
    v_add_f32 v22, v48, v52
    v_add_f32 v23, v50, v54
    v_add_f32 v26, v56, v60
    v_add_f32 v27, v58, v62
    v_add_f32 v20, v20, v24
    v_add_f32 v21, v21, v25
    v_add_f32 v24, v22, v26
    v_add_f32 v25, v23, v27
    s_branch L_x1_sum
L_A_idle:
    v_mov_b32 v28, 0
    v_mov_b32 v29, 0
    v_mov_b32 v24, 2176
    ds_write_b64 v1, v[28:29]
    ds_write_b64 v24, v[28:29]
    s_waitcnt lgkmcnt(0)
    s_barrier
    s_endpgm
L_B:
L_pad3:
    s_cbranch_execz L_common
    s_cmp_lg_u32 s31, 0
    s_cbranch_scc1 L_end
    v_lshrrev_b32 v1, 3, v7
    s_lshl_b32 s26, s24, 17
    s_lshl_b32 s27, s25, 9
    s_add_u32 s26, s26, s27
    s_add_u32 s30, s3, 3
    s_and_b32 s30, s30, 3
    s_lshl_b32 s27, s30, 7
    s_add_u32 s26, s26, s27
    s_add_u32 s26, s26, 4096
    v_lshlrev_b32 v3, 14, v1
    v_lshl_add_u32 v3, v2, 4, v3
    v_add_u32 v3, s26, v3
    v_add_u32 v4, 8192, v3
    v_lshlrev_b32 v5, 4, v1
    v_mov_b32 v24, 2176
    v_mov_b32 v26, 0
    v_mov_b32 v27, 0
    ds_write_b64 v24, v[26:27]
    s_waitcnt lgkmcnt(0)
    s_load_dwordx2 s[40:41], s[20:21], 520200
    s_lshl_b32 s26, s25, 17
    s_lshl_b32 s27, s30, 15
    s_add_u32 s26, s26, s27
    s_lshl_b32 s27, s24, 6
    s_add_u32 s26, s26, s27
    s_add_u32 s26, s26, 524288
    v_and_b32 v6, 3, v0
    v_lshlrev_b32 v6, 4, v6
    v_bfe_u32 v1, v0, 2, 1
    v_lshl_add_u32 v6, v1, 12, v6
    v_bfe_u32 v1, v0, 4, 2
    v_lshl_add_u32 v6, v1, 13, v6
    v_add_u32 v6, s26, v6
    s_lshl_b32 s26, s22, 10
    s_add_u32 s26, s26, 491520
    s_lshl_b32 s37, s23, 3
    s_add_u32 s26, s26, s37
    v_mov_b32 v28, s26
    s_mov_b32 s46, 0x00110011
    s_mov_b32 s47, 0x00110011
    s_mov_b64 exec, s[46:47]
    global_load_dword v26, v6, s[20:21] sc1
    s_mov_b64 exec, -1
    s_cmp_lg_u32 s3, 4
    s_cbranch_scc1 L_B_nowarm
    s_setprio 3
    s_mov_b64 exec, 1
    global_load_dword v26, v28, s[20:21] sc1
    s_lshl_b32 s26, s22, 8
    s_bfe_u32 s27, s23, 0x10003
    s_lshl_b32 s27, s27, 7
    s_add_u32 s26, s26, s27
    s_mov_b64 exec, 3
    v_lshl_add_u32 v27, v7, 6, s26
    global_load_dword v26, v27, s[16:17]
    s_lshl_b32 s26, s25, 10
    s_lshl_b32 s27, s24, 13
    s_add_u32 s26, s26, s27
    s_mov_b64 exec, 0xffff
    v_lshl_add_u32 v27, v7, 6, s26
    global_load_dword v26, v27, s[20:21] sc1
    s_cmp_eq_u32 s32, 0
    s_cbranch_scc1 L_B_nowarm0
    v_add_u32 v27, 4096, v27
    global_load_dword v26, v27, s[20:21] sc1
L_B_nowarm0:
    s_mov_b64 exec, -1
L_B_nowarm:
    v_and_b32 v1, 8, v0
    v_cmp_eq_u32 vcc, 0, v1
    s_mov_b32 s35, 3200000
    v_mov_b64 v[12:13], 0
    v_mov_b64 v[14:15], 0
    v_mov_b64 v[16:17], 0
    v_mov_b64 v[18:19], 0
    s_waitcnt lgkmcnt(0)
    s_add_u32 s40, s40, 0x7F4A7C15
    s_add_u32 s41, s41, 0x9E3779B9
    v_mov_b32 v21, s40
    v_mov_b32 v23, s41
    v_mov_b32 v30, s40
    v_mov_b32 v31, s41
    s_barrier
    s_setprio 3
    global_load_dwordx4 v[32:35], v3, s[14:15] offset:-4096 nt
    global_load_dwordx4 v[36:39], v3, s[14:15] offset:-2048 nt
    s_setprio 2
    global_load_dwordx4 v[40:43], v3, s[14:15] offset:0 nt
    global_load_dwordx4 v[44:47], v3, s[14:15] offset:2048 nt
    s_setprio 1
    global_load_dwordx4 v[48:51], v4, s[14:15] offset:-4096 nt
    global_load_dwordx4 v[52:55], v4, s[14:15] offset:-2048 nt
    s_setprio 0
    global_load_dwordx4 v[56:59], v4, s[14:15] offset:0 nt
    global_load_dwordx4 v[60:63], v4, s[14:15] offset:2048 nt
    s_waitcnt vmcnt(6)
    v_perm_b32 v64, v36, v32, s28
    v_perm_b32 v65, v36, v32, s29
    v_perm_b32 v66, v37, v33, s28
    v_perm_b32 v67, v37, v33, s29
    v_perm_b32 v68, v38, v34, s28
    v_perm_b32 v69, v38, v34, s29
    v_perm_b32 v70, v39, v35, s28
    v_perm_b32 v71, v39, v35, s29
    s_waitcnt vmcnt(4)
    v_perm_b32 v72, v44, v40, s28
    v_perm_b32 v73, v44, v40, s29
    v_perm_b32 v74, v45, v41, s28
    v_perm_b32 v75, v45, v41, s29
    v_perm_b32 v76, v46, v42, s28
    v_perm_b32 v77, v46, v42, s29
    v_perm_b32 v78, v47, v43, s28
    v_perm_b32 v79, v47, v43, s29
    s_waitcnt vmcnt(2)
    v_perm_b32 v80, v52, v48, s28
    v_perm_b32 v81, v52, v48, s29
    v_perm_b32 v82, v53, v49, s28
    v_perm_b32 v83, v53, v49, s29
    v_perm_b32 v84, v54, v50, s28
    v_perm_b32 v85, v54, v50, s29
    v_perm_b32 v86, v55, v51, s28
    v_perm_b32 v87, v55, v51, s29
    s_waitcnt vmcnt(0)
    v_perm_b32 v88, v60, v56, s28
    v_perm_b32 v89, v60, v56, s29
    v_perm_b32 v90, v61, v57, s28
    v_perm_b32 v91, v61, v57, s29
    v_perm_b32 v92, v62, v58, s28
    v_perm_b32 v93, v62, v58, s29
    v_perm_b32 v94, v63, v59, s28
    v_perm_b32 v95, v63, v59, s29
L_pad4:
    s_cbranch_execz L_common
L_B_wait:
    ds_read_b32 v25, v24
    ds_read_b128 v[8:11], v5 offset:2048
    s_sub_u32 s35, s35, 1
    s_cbranch_scc1 L_end
    s_waitcnt lgkmcnt(1)
    v_readfirstlane_b32 s34, v25
    s_cmp_eq_u32 s34, 0
    s_waitcnt lgkmcnt(0)
    s_cbranch_scc1 L_B_wait
    v_dot2c_f32_bf16 v12, v64, v8
    v_dot2c_f32_bf16 v13, v65, v8
    v_dot2c_f32_bf16 v14, v66, v8
    v_dot2c_f32_bf16 v15, v67, v8
    v_dot2c_f32_bf16 v16, v68, v8
    v_dot2c_f32_bf16 v17, v69, v8
    v_dot2c_f32_bf16 v18, v70, v8
    v_dot2c_f32_bf16 v19, v71, v8
    v_dot2c_f32_bf16 v12, v72, v9
    v_dot2c_f32_bf16 v13, v73, v9
    v_dot2c_f32_bf16 v14, v74, v9
    v_dot2c_f32_bf16 v15, v75, v9
    v_dot2c_f32_bf16 v16, v76, v9
    v_dot2c_f32_bf16 v17, v77, v9
    v_dot2c_f32_bf16 v18, v78, v9
    v_dot2c_f32_bf16 v19, v79, v9
    v_dot2c_f32_bf16 v12, v80, v10
    v_dot2c_f32_bf16 v13, v81, v10
    v_dot2c_f32_bf16 v14, v82, v10
    v_dot2c_f32_bf16 v15, v83, v10
    v_dot2c_f32_bf16 v16, v84, v10
    v_dot2c_f32_bf16 v17, v85, v10
    v_dot2c_f32_bf16 v18, v86, v10
    v_dot2c_f32_bf16 v19, v87, v10
    v_dot2c_f32_bf16 v12, v88, v11
    v_dot2c_f32_bf16 v13, v89, v11
    v_dot2c_f32_bf16 v14, v90, v11
    v_dot2c_f32_bf16 v15, v91, v11
    v_dot2c_f32_bf16 v16, v92, v11
    v_dot2c_f32_bf16 v17, v93, v11
    v_dot2c_f32_bf16 v18, v94, v11
    v_dot2c_f32_bf16 v19, v95, v11
    s_cmp_eq_u32 s3, 7
    s_nop 1
    v_permlane32_swap_b32 v12, v16
    v_permlane32_swap_b32 v13, v17
    v_permlane32_swap_b32 v14, v18
    v_permlane32_swap_b32 v15, v19
    v_add_f32 v12, v12, v16
    v_add_f32 v13, v13, v17
    v_add_f32 v14, v14, v18
    v_add_f32 v15, v15, v19
    s_nop 0
    v_permlane16_swap_b32 v12, v14
    v_permlane16_swap_b32 v13, v15
    v_add_f32 v12, v12, v14
    v_add_f32 v13, v13, v15
    s_nop 0
    v_add_f32_dpp v20, v12, v12 row_ror:8 row_mask:0xf bank_mask:0xf
    v_add_f32_dpp v22, v13, v13 row_ror:8 row_mask:0xf bank_mask:0xf
    s_cbranch_scc0 L_B_nofl
    s_mov_b64 exec, 1
    global_store_dwordx2 v28, v[30:31], s[20:21]
L_B_nofl:
    s_mov_b64 exec, vcc
    global_store_dwordx4 v6, v[20:23], s[20:21] sc1
L_B_done:
L_end:
    s_endpgm
.section .rodata,"a"
.p2align 6
.amdhsa_kernel standalone__geglu_ffn__decode_kernel
  .amdhsa_next_free_vgpr 108
  .amdhsa_next_free_sgpr 64
  .amdhsa_accum_offset 108
  .amdhsa_group_segment_fixed_size 0
  .amdhsa_kernarg_size 56
  .amdhsa_user_sgpr_count 2
  .amdhsa_user_sgpr_kernarg_segment_ptr 1
  .amdhsa_system_sgpr_workgroup_id_x 1
.end_amdhsa_kernel
```
